```python
import torch

def _softmax(x, axis=-1):
    return torch.softmax(x, dim=axis)
def _gelu(x):
    return torch.nn.functional.gelu(x, approximate="tanh")
def _silu(x):
    return torch.nn.functional.silu(x)
def _sigmoid(x):
    return torch.sigmoid(x)
def _layernorm(x, axis=-1, eps=1e-5):
    m = x.mean(dim=axis, keepdim=True)
    v = x.var(dim=axis, keepdim=True, unbiased=False)
    return (x - m) / torch.sqrt(v + eps)
def _scatter_add(tgt, idx, src, axis=0):
    return tgt.clone().index_add_(axis, idx, src)
def _segment_sum(src, seg, n):
    out = torch.zeros((n,) + src.shape[1:], dtype=src.dtype)
    return out.index_add_(0, seg, src)
def _pad(x, pw):
    flat = tuple(v for pair in reversed(pw) for v in pair)
    return torch.nn.functional.pad(x, flat)

kernel_name = 'standalone__kv_cache_quant_int4_int2_kv_with_per_channel_or_per_token_scales__decode'

def setup_inputs():

    _w = (lambda a: (lambda t: t.to(torch.bfloat16) if t.is_floating_point() else t)(torch.as_tensor(a)))
    B = 4
    Sq = 1
    Skv = 8192
    Hq = 32
    Hkv = 8
    Dh = 128
    bits = 2
    G = 64
    if G <= 0 or G >= Skv:
        G = max(1, Skv // 2)
    Skv = (Skv // G) * G
    ngk = Skv // G
    qmax = (1 << bits) - 1
    return {
        "q": _w((lambda *s: torch.randn(*s, dtype=torch.bfloat16) * 3.2)(B, Hq, Sq, Dh)),
        "qk": _w(torch.randint(0, qmax + 1, (B, Hkv, Skv, Dh)).to(torch.int32)),
        "qv": _w(torch.randint(0, qmax + 1, (B, Hkv, Skv, Dh)).to(torch.int32)),
        "k_scales": _w(torch.abs((lambda *s: torch.randn(*s, dtype=torch.bfloat16) * 3.2)(B, Hkv, ngk, Dh)) * 0.05 + 0.02),
        "k_zeros": _w((lambda *s: torch.randn(*s, dtype=torch.bfloat16) * 3.2)(B, Hkv, ngk, Dh) + float(qmax) / 2.0),
        "v_scales": _w(torch.abs((lambda *s: torch.randn(*s, dtype=torch.bfloat16) * 0.05)(B, Hkv, Skv, 1)) * 0.05 + 0.02),
        "v_zeros": _w((lambda *s: torch.randn(*s, dtype=torch.bfloat16) * 0.05)(B, Hkv, Skv, 1) + float(qmax) / 2.0),
    }

def reference(q, qk, qv, k_scales, k_zeros, v_scales, v_zeros):
    B, Hq, Sq, Dh = q.shape
    Hkv, Skv = qk.shape[1], qk.shape[2]
    ngk = k_scales.shape[2]
    G = Skv // ngk
    ks = (lambda x, n, axis: torch.repeat_interleave(x, n, dim=axis))(k_scales, G, axis=2)
    kz = (lambda x, n, axis: torch.repeat_interleave(x, n, dim=axis))(k_zeros, G, axis=2)
    k = ((lambda x, dt: x.to(dt))(qk, q.dtype) - kz) * ks
    v = ((lambda x, dt: x.to(dt))(qv, q.dtype) - v_zeros) * v_scales
    rep = Hq // Hkv
    if rep > 1:
        k = (lambda x, n, axis: torch.repeat_interleave(x, n, dim=axis))(k, rep, axis=1)
        v = (lambda x, n, axis: torch.repeat_interleave(x, n, dim=axis))(v, rep, axis=1)
    scale = float(Dh) ** -0.5
    logits = torch.einsum("bhqd,bhkd->bhqk", q, k) * scale
    p = _softmax(logits, axis=-1)
    o = torch.einsum("bhqk,bhkd->bhqd", p, v)
    return o
```

```asm
; @launch grid=(256,1,1) block=(256,1,1) lds=39424
.amdgcn_target "amdgcn-amd-amdhsa--gfx950"
.text
.globl standalone__kv_cache_quant_int4_int2_kv_with_per_channel_or_per_token_scales__decode_kernel
.p2align 8
.type standalone__kv_cache_quant_int4_int2_kv_with_per_channel_or_per_token_scales__decode_kernel,@function
standalone__kv_cache_quant_int4_int2_kv_with_per_channel_or_per_token_scales__decode_kernel:
    s_cmp_ge_u32 s2, 256
    s_cbranch_scc1 L_exit
    v_lshrrev_b32 v68, 6, v0
    s_load_dwordx2 s[8:9], s[0:1], 8
    s_load_dwordx2 s[20:21], s[0:1], 24
    s_load_dwordx2 s[24:25], s[0:1], 32
    s_load_dwordx2 s[28:29], s[0:1], 40
    s_load_dwordx2 s[32:33], s[0:1], 48
    s_load_dwordx2 s[16:17], s[0:1], 0
    s_load_dwordx2 s[12:13], s[0:1], 16
    v_readfirstlane_b32 s3, v68
    s_and_b32 s49, s2, 7
    s_lshr_b32 s48, s2, 3
    s_lshl_b32 s52, s48, 10
    s_lshl_b32 s51, s3, 8
    s_add_u32 s52, s52, s51
    s_add_u32 s66, s51, 30208
    s_getpc_b64 s[84:85]
L_pc:
    s_lshr_b32 s50, s2, 3
    s_lshl_b32 s50, s50, 2
    s_add_u32 s50, s50, s3
    s_lshl_b32 s50, s50, 7
    s_min_u32 s50, s50, L_exit-L_pc
    s_load_dword s86, s[84:85], s50
    v_and_b32 v2, 63, v0
    s_mov_b32 s10, 134217728
    s_mov_b32 s11, 0x20000
    s_mov_b32 s14, 134217728
    s_mov_b32 s15, 0x20000
    s_mov_b32 s18, 32768
    s_mov_b32 s19, 0x20000
    s_mov_b32 s22, 1048576
    s_mov_b32 s23, 0x20000
    s_mov_b32 s26, 1048576
    s_mov_b32 s27, 0x20000
    s_mov_b32 s30, 524288
    s_mov_b32 s31, 0x20000
    s_mov_b32 s34, 524288
    s_mov_b32 s35, 0x20000
    s_lshl_b32 s50, s48, 22
    s_lshl_b32 s60, s49, 19
    s_or_b32 s60, s60, s50
    s_bfe_i32 s51, s3, 65536
    s_and_b32 s51, s51, 34816
    s_xor_b32 s2, s60, s51
    s_bfe_i32 s51, s3, 65537
    s_and_b32 s51, s51, 81920
    s_xor_b32 s2, s2, s51
    s_and_b32 s51, s49, 3
    s_lshl_b32 s51, s51, 17
    s_xor_b32 s2, s2, s51
    s_xor_b32 s56, s2, 32768
    v_and_b32 v90, 15, v2
    v_lshrrev_b32 v91, 4, v2
    v_lshlrev_b32 v70, 12, v91
    v_lshl_or_b32 v1, v90, 4, v70
    v_lshlrev_b32 v15, 4, v2
    s_lshl_b32 s51, s3, 10
    s_lshr_b32 s4, s60, 7
    s_add_u32 s4, s4, s51
    s_add_u32 s6, s51, 17920
    s_lshl_b32 s51, s3, 9
    s_lshr_b32 s5, s60, 8
    s_add_u32 s5, s5, s51
    s_add_u32 s7, s51, 26112
    s_mov_b32 m0, s6
    s_waitcnt lgkmcnt(0)
    buffer_load_dwordx4 v[124:127], v1, s[8:11], s2 offen offset:0 nt
    buffer_load_dwordx4 v[128:131], v1, s[8:11], s2 offen offset:256 nt
    buffer_load_dwordx4 v[132:135], v1, s[8:11], s2 offen offset:512 nt
    buffer_load_dwordx4 v[136:139], v1, s[8:11], s2 offen offset:768 nt
    buffer_load_dwordx4 v[140:143], v1, s[8:11], s2 offen offset:1024 nt
    buffer_load_dwordx4 v[144:147], v1, s[8:11], s2 offen offset:1280 nt
    buffer_load_dwordx4 v[148:151], v1, s[8:11], s2 offen offset:1536 nt
    buffer_load_dwordx4 v[152:155], v1, s[8:11], s2 offen offset:1792 nt
    buffer_load_dwordx4 v15, s[20:23], s4 offen nt lds
    s_add_u32 m0, s6, 4096
    s_nop 0
    buffer_load_dwordx4 v15, s[24:27], s4 offen nt lds
    s_mov_b32 exec_hi, 0
    s_mov_b32 m0, s7
    s_nop 0
    buffer_load_dwordx4 v15, s[28:31], s5 offen nt lds
    s_add_u32 m0, s7, 2048
    s_nop 0
    buffer_load_dwordx4 v15, s[32:35], s5 offen nt lds
    s_mov_b32 exec_lo, 0xffff
    s_mov_b32 m0, s66
    s_nop 0
    buffer_load_dwordx4 v15, s[16:19], s52 offen  lds
    s_mov_b64 exec, -1
    s_load_dwordx2 s[44:45], s[0:1], 72
    s_load_dwordx2 s[36:37], s[0:1], 56
    s_load_dwordx2 s[40:41], s[0:1], 8
    s_load_dwordx2 s[88:89], s[0:1], 8
    s_mov_b32 s42, 134217728
    s_mov_b32 s43, 0x20000
    s_mov_b32 s90, 134217728
    s_mov_b32 s91, 0x20000
    s_mov_b32 s38, 32768
    s_mov_b32 s39, 0x20000
    s_mov_b32 s46, 1114112
    s_mov_b32 s47, 0x20000
    v_lshlrev_b32 v4, 3, v90
    v_lshrrev_b32 v5, 8, v70
    v_and_b32 v71, 3, v2
    v_lshl_or_b32 v5, v71, 1, v5
    s_mul_i32 s51, s3, 4352
    v_mul_u32_u24 v3, 1088, v91
    v_add3_u32 v3, v3, v4, s51
    v_mul_u32_u24 v8, 272, v90
    v_lshl_add_u32 v8, v91, 4, v8
    v_add_u32 v8, s51, v8
    v_bfe_u32 v193, v2, 2, 2
    v_lshlrev_b32 v193, 8, v193
    v_lshl_or_b32 v193, v91, 4, v193
    s_lshl_b32 s50, s3, 11
    s_add_u32 s50, s50, 31232
    v_lshrrev_b32 v27, 2, v2
    v_lshl_add_u32 v27, v27, 3, s50
    v_mov_b32 v194, v27
    s_mov_b32 s53, 0x3fb8aa3b
    s_mov_b32 s54, 0x3db504f3
    s_mov_b32 s64, 0x11111111
    s_mov_b32 s65, 0x11111111
    s_mov_b32 s55, 0xffff0000
    s_mov_b32 s59, 0
    s_lshl_b32 s67, s48, 15
    s_lshl_b32 s50, s3, 10
    s_add_u32 s67, s67, s50
    s_lshl_b32 s70, s49, 12
    s_add_u32 s70, s70, s67
    s_mul_i32 s69, s48, 1280
    s_add_u32 s69, s69, 1048576
    s_xor_b32 s77, s70, 4096
    s_xor_b32 s78, s70, 8192
    s_xor_b32 s79, s70, 12288
    s_xor_b32 s80, s70, 16384
    s_xor_b32 s81, s70, 20480
    s_xor_b32 s82, s70, 24576
    s_xor_b32 s83, s70, 28672
    s_mov_b32 s76, 7
    s_and_b32 s61, s48, 7
    s_xor_b32 s61, s61, s49
    v_and_b32 v74, 1, v2
    v_lshlrev_b32 v74, 4, v74
    v_mov_b32 v75, 0xffff
    v_lshlrev_b32 v75, v74, v75
    v_bfe_i32 v74, v2, 1, 1
    v_and_b32 v7, v74, v75
    v_xor_b32 v6, v7, v75
    v_mov_b32 v10, 0xff800000
    v_mov_b32 v11, 0
    v_mov_b32 v60, 0
    v_mov_b32 v61, 0
    v_mov_b32 v62, 0
    v_mov_b32 v63, 0
    v_mov_b32 v64, 0
    v_mov_b32 v65, 0
    v_mov_b32 v66, 0
    v_mov_b32 v67, 0
    v_lshlrev_b32 v188, 4, v90
    v_lshl_or_b32 v188, v91, 9, v188
    v_add_u32 v188, s51, v188
    v_lshlrev_b32 v68, 3, v2
    s_lshl_b32 s50, s3, 3
    s_add_u32 s50, s50, 17408
    v_add_u32 v189, s50, v68
    s_lshl_b32 s50, s3, 9
    v_add_u32 v190, s50, v68
    s_lshl_b32 s50, s3, 5
    s_add_u32 s50, s50, 17408
    v_mov_b32 v191, s50
    v_lshl_add_u32 v192, v2, 2, s52
    s_waitcnt lgkmcnt(0)
    s_load_dword s68, s[44:45], s69
    s_waitcnt vmcnt(12)
    buffer_load_dwordx4 v[156:159], v1, s[8:11], s56 offen offset:0 nt
    s_waitcnt vmcnt(11)
    buffer_load_dwordx4 v[160:163], v1, s[8:11], s56 offen offset:256 nt
    s_waitcnt vmcnt(10)
    buffer_load_dwordx4 v[164:167], v1, s[8:11], s56 offen offset:512 nt
    s_waitcnt vmcnt(9)
    buffer_load_dwordx4 v[168:171], v1, s[8:11], s56 offen offset:768 nt
    s_waitcnt vmcnt(8)
    buffer_load_dwordx4 v[172:175], v1, s[8:11], s56 offen offset:1024 nt
    s_waitcnt vmcnt(7)
    buffer_load_dwordx4 v[176:179], v1, s[8:11], s56 offen offset:1280 nt
    s_waitcnt vmcnt(6)
    s_barrier
    s_bfe_u32 s50, s2, 262159
    s_lshl_b32 s62, s50, 8
    v_add_u32 v9, s62, v4
    ds_read_b64 v[16:17], v9 offset:17920
    ds_read_b64 v[18:19], v9 offset:18048
    ds_read_b64 v[20:21], v9 offset:22016
    ds_read_b64 v[22:23], v9 offset:22144
    ds_read_b128 v[28:31], v193 offset:30208
    ds_read_b128 v[32:35], v193 offset:30272
    ds_read_b128 v[36:39], v193 offset:30336
    ds_read_b128 v[40:43], v193 offset:30400
L_kloop:
    s_add_u32 s51, s59, 2
    s_and_b32 s50, s51, 15
    s_lshl_b32 s57, s50, 15
    s_xor_b32 s57, s57, s2
    s_cmp_lt_u32 s51, 16
    s_cselect_b64 s[88:89], s[8:9], s[12:13]
    s_waitcnt vmcnt(5)
    buffer_load_dwordx4 v[180:183], v1, s[40:43], s56 offen offset:1536 nt
    v_cvt_f32_i32 v84, v124
    v_cvt_f32_i32 v85, v125
    v_cvt_f32_i32 v86, v126
    v_cvt_f32_i32 v87, v127
    s_waitcnt lgkmcnt(0)
    v_mfma_f32_16x16x32_bf16 v[76:79], v[92:95], v[28:31], 0
    v_mfma_f32_16x16x32_bf16 v[76:79], v[96:99], v[32:35], v[76:79]
    v_mfma_f32_16x16x32_bf16 v[76:79], v[100:103], v[36:39], v[76:79]
    v_mfma_f32_16x16x32_bf16 v[76:79], v[104:107], v[40:43], v[76:79]
    v_lshlrev_b32 v44, 16, v20
    v_and_b32 v45, s55, v20
    v_and_b32 v52, 0xffff, v16
    v_and_b32 v53, s55, v16
    v_lshlrev_b32 v46, 16, v21
    v_and_b32 v47, s55, v21
    v_and_b32 v54, 0xffff, v17
    v_and_b32 v55, s55, v17
    v_lshlrev_b32 v48, 16, v22
    v_and_b32 v49, s55, v22
    v_and_b32 v56, 0xffff, v18
    v_and_b32 v57, s55, v18
    v_lshlrev_b32 v50, 16, v23
    v_and_b32 v51, s55, v23
    v_and_b32 v58, 0xffff, v19
    v_and_b32 v59, s55, v19
    v_pk_add_f32 v[84:85], v[84:85], v[44:45] neg_lo:[0,1] neg_hi:[0,1]
    v_pk_add_f32 v[86:87], v[86:87], v[46:47] neg_lo:[0,1] neg_hi:[0,1]
    v_cvt_pk_bf16_f32 v68, v84, v85
    v_cvt_pk_bf16_f32 v69, v86, v87
    v_dot2_f32_bf16 v84, v68, v52, 0
    v_dot2_f32_bf16 v85, v68, v53, 0
    v_dot2_f32_bf16 v86, v69, v54, 0
    v_dot2_f32_bf16 v87, v69, v55, 0
    s_nop 0
    v_cvt_pk_bf16_f32 v68, v84, v85
    s_nop 0
    v_cvt_pk_bf16_f32 v69, v86, v87
    ds_write_b64 v3, v[68:69] offset:0
    s_waitcnt vmcnt(4)
    buffer_load_dwordx4 v[184:187], v1, s[40:43], s56 offen offset:1792 nt
    v_cvt_f32_i32 v88, v128
    v_cvt_f32_i32 v89, v129
    v_cvt_f32_i32 v90, v130
    v_cvt_f32_i32 v91, v131
    v_pk_add_f32 v[88:89], v[88:89], v[48:49] neg_lo:[0,1] neg_hi:[0,1]
    v_pk_add_f32 v[90:91], v[90:91], v[50:51] neg_lo:[0,1] neg_hi:[0,1]
    v_cvt_pk_bf16_f32 v70, v88, v89
    v_cvt_pk_bf16_f32 v71, v90, v91
    v_dot2_f32_bf16 v88, v70, v56, 0
    v_dot2_f32_bf16 v89, v70, v57, 0
    v_dot2_f32_bf16 v90, v71, v58, 0
    v_dot2_f32_bf16 v91, v71, v59, 0
    s_nop 0
    v_cvt_pk_bf16_f32 v70, v88, v89
    s_nop 0
    v_cvt_pk_bf16_f32 v71, v90, v91
    ds_write_b64 v3, v[70:71] offset:128
    s_cmp_eq_u32 s59, 0
    s_cbranch_scc1 L_norn
    v_cvt_pk_bf16_f32 v80, v76, v77
    v_cvt_pk_bf16_f32 v81, v78, v79
    v_lshlrev_b32 v76, 16, v80
    v_and_b32 v77, s55, v80
    v_lshlrev_b32 v78, 16, v81
    v_and_b32 v79, s55, v81
    v_mul_f32 v76, s54, v76
    v_mul_f32 v77, s54, v77
    v_mul_f32 v78, s54, v78
    v_mul_f32 v79, s54, v79
    v_cvt_pk_bf16_f32 v80, v76, v77
    v_cvt_pk_bf16_f32 v81, v78, v79
    s_mov_b64 exec, s[64:65]
    ds_write_b64 v194, v[80:81]
    s_mov_b64 exec, -1
    v_max3_f32 v10, v10, v76, v77
    v_max3_f32 v10, v10, v78, v79
    v_add_u32 v194, 128, v194
L_norn:
    s_waitcnt vmcnt(5)
    buffer_load_dwordx4 v[124:127], v1, s[88:91], s57 offen offset:0 nt
    v_cvt_f32_i32 v84, v132
    v_cvt_f32_i32 v85, v133
    v_cvt_f32_i32 v86, v134
    v_cvt_f32_i32 v87, v135
    v_pk_add_f32 v[84:85], v[84:85], v[44:45] neg_lo:[0,1] neg_hi:[0,1]
    v_pk_add_f32 v[86:87], v[86:87], v[46:47] neg_lo:[0,1] neg_hi:[0,1]
    v_cvt_pk_bf16_f32 v72, v84, v85
    v_cvt_pk_bf16_f32 v73, v86, v87
    v_dot2_f32_bf16 v84, v72, v52, 0
    v_dot2_f32_bf16 v85, v72, v53, 0
    v_dot2_f32_bf16 v86, v73, v54, 0
    v_dot2_f32_bf16 v87, v73, v55, 0
    s_nop 0
    v_cvt_pk_bf16_f32 v72, v84, v85
    s_nop 0
    v_cvt_pk_bf16_f32 v73, v86, v87
    ds_write_b64 v3, v[72:73] offset:272
    s_waitcnt vmcnt(4)
    buffer_load_dwordx4 v[128:131], v1, s[88:91], s57 offen offset:256 nt
    v_cvt_f32_i32 v88, v136
    v_cvt_f32_i32 v89, v137
    v_cvt_f32_i32 v90, v138
    v_cvt_f32_i32 v91, v139
    v_pk_add_f32 v[88:89], v[88:89], v[48:49] neg_lo:[0,1] neg_hi:[0,1]
    v_pk_add_f32 v[90:91], v[90:91], v[50:51] neg_lo:[0,1] neg_hi:[0,1]
    v_cvt_pk_bf16_f32 v74, v88, v89
    v_cvt_pk_bf16_f32 v75, v90, v91
    v_dot2_f32_bf16 v88, v74, v56, 0
    v_dot2_f32_bf16 v89, v74, v57, 0
    v_dot2_f32_bf16 v90, v75, v58, 0
    v_dot2_f32_bf16 v91, v75, v59, 0
    s_nop 0
    v_cvt_pk_bf16_f32 v74, v88, v89
    s_nop 0
    v_cvt_pk_bf16_f32 v75, v90, v91
    ds_write_b64 v3, v[74:75] offset:400
    s_bfe_u32 s50, s56, 262159
    s_lshl_b32 s62, s50, 8
    v_add_u32 v9, s62, v4
    ds_read_b64 v[16:17], v9 offset:17920
    ds_read_b64 v[18:19], v9 offset:18048
    ds_read_b64 v[20:21], v9 offset:22016
    ds_read_b64 v[22:23], v9 offset:22144
    s_waitcnt vmcnt(5)
    buffer_load_dwordx4 v[132:135], v1, s[88:91], s57 offen offset:512 nt
    v_cvt_f32_i32 v84, v140
    v_cvt_f32_i32 v85, v141
    v_cvt_f32_i32 v86, v142
    v_cvt_f32_i32 v87, v143
    v_pk_add_f32 v[84:85], v[84:85], v[44:45] neg_lo:[0,1] neg_hi:[0,1]
    v_pk_add_f32 v[86:87], v[86:87], v[46:47] neg_lo:[0,1] neg_hi:[0,1]
    v_cvt_pk_bf16_f32 v68, v84, v85
    v_cvt_pk_bf16_f32 v69, v86, v87
    v_dot2_f32_bf16 v84, v68, v52, 0
    v_dot2_f32_bf16 v85, v68, v53, 0
    v_dot2_f32_bf16 v86, v69, v54, 0
    v_dot2_f32_bf16 v87, v69, v55, 0
    s_nop 0
    v_cvt_pk_bf16_f32 v68, v84, v85
    s_nop 0
    v_cvt_pk_bf16_f32 v69, v86, v87
    ds_write_b64 v3, v[68:69] offset:544
    s_waitcnt vmcnt(4)
    buffer_load_dwordx4 v[136:139], v1, s[88:91], s57 offen offset:768 nt
    v_cvt_f32_i32 v88, v144
    v_cvt_f32_i32 v89, v145
    v_cvt_f32_i32 v90, v146
    v_cvt_f32_i32 v91, v147
    v_pk_add_f32 v[88:89], v[88:89], v[48:49] neg_lo:[0,1] neg_hi:[0,1]
    v_pk_add_f32 v[90:91], v[90:91], v[50:51] neg_lo:[0,1] neg_hi:[0,1]
    v_cvt_pk_bf16_f32 v70, v88, v89
    v_cvt_pk_bf16_f32 v71, v90, v91
    v_dot2_f32_bf16 v88, v70, v56, 0
    v_dot2_f32_bf16 v89, v70, v57, 0
    v_dot2_f32_bf16 v90, v71, v58, 0
    v_dot2_f32_bf16 v91, v71, v59, 0
    s_nop 0
    v_cvt_pk_bf16_f32 v70, v88, v89
    s_nop 0
    v_cvt_pk_bf16_f32 v71, v90, v91
    ds_write_b64 v3, v[70:71] offset:672
    s_waitcnt vmcnt(5)
    buffer_load_dwordx4 v[140:143], v1, s[88:91], s57 offen offset:1024 nt
    v_cvt_f32_i32 v84, v148
    v_cvt_f32_i32 v85, v149
    v_cvt_f32_i32 v86, v150
    v_cvt_f32_i32 v87, v151
    v_pk_add_f32 v[84:85], v[84:85], v[44:45] neg_lo:[0,1] neg_hi:[0,1]
    v_pk_add_f32 v[86:87], v[86:87], v[46:47] neg_lo:[0,1] neg_hi:[0,1]
    v_cvt_pk_bf16_f32 v72, v84, v85
    v_cvt_pk_bf16_f32 v73, v86, v87
    v_dot2_f32_bf16 v84, v72, v52, 0
    v_dot2_f32_bf16 v85, v72, v53, 0
    v_dot2_f32_bf16 v86, v73, v54, 0
    v_dot2_f32_bf16 v87, v73, v55, 0
    s_nop 0
    v_cvt_pk_bf16_f32 v72, v84, v85
    s_nop 0
    v_cvt_pk_bf16_f32 v73, v86, v87
    ds_write_b64 v3, v[72:73] offset:816
    s_waitcnt vmcnt(4)
    buffer_load_dwordx4 v[144:147], v1, s[88:91], s57 offen offset:1280 nt
    v_cvt_f32_i32 v88, v152
    v_cvt_f32_i32 v89, v153
    v_cvt_f32_i32 v90, v154
    v_cvt_f32_i32 v91, v155
    v_pk_add_f32 v[88:89], v[88:89], v[48:49] neg_lo:[0,1] neg_hi:[0,1]
    v_pk_add_f32 v[90:91], v[90:91], v[50:51] neg_lo:[0,1] neg_hi:[0,1]
    v_cvt_pk_bf16_f32 v74, v88, v89
    v_cvt_pk_bf16_f32 v75, v90, v91
    v_dot2_f32_bf16 v88, v74, v56, 0
    v_dot2_f32_bf16 v89, v74, v57, 0
    v_dot2_f32_bf16 v90, v75, v58, 0
    v_dot2_f32_bf16 v91, v75, v59, 0
    s_nop 0
    v_cvt_pk_bf16_f32 v74, v88, v89
    s_nop 0
    v_cvt_pk_bf16_f32 v75, v90, v91
    ds_write_b64 v3, v[74:75] offset:944
    ds_read_b128 v[92:95], v8 offset:0
    ds_read_b128 v[96:99], v8 offset:64
    ds_read_b128 v[100:103], v8 offset:128
    ds_read_b128 v[104:107], v8 offset:192
    s_add_u32 s59, s59, 1
    s_mov_b32 s56, s57
    s_mov_b64 s[40:41], s[88:89]
    s_add_u32 s51, s59, 2
    s_and_b32 s50, s51, 15
    s_lshl_b32 s57, s50, 15
    s_xor_b32 s57, s57, s2
    s_cmp_lt_u32 s51, 16
    s_cselect_b64 s[88:89], s[8:9], s[12:13]
    s_waitcnt vmcnt(5)
    buffer_load_dwordx4 v[148:151], v1, s[40:43], s56 offen offset:1536 nt
    v_cvt_f32_i32 v84, v156
    v_cvt_f32_i32 v85, v157
    v_cvt_f32_i32 v86, v158
    v_cvt_f32_i32 v87, v159
    s_waitcnt lgkmcnt(0)
    v_mfma_f32_16x16x32_bf16 v[76:79], v[92:95], v[28:31], 0
    v_mfma_f32_16x16x32_bf16 v[76:79], v[96:99], v[32:35], v[76:79]
    v_mfma_f32_16x16x32_bf16 v[76:79], v[100:103], v[36:39], v[76:79]
    v_mfma_f32_16x16x32_bf16 v[76:79], v[104:107], v[40:43], v[76:79]
    v_lshlrev_b32 v44, 16, v20
    v_and_b32 v45, s55, v20
    v_and_b32 v52, 0xffff, v16
    v_and_b32 v53, s55, v16
    v_lshlrev_b32 v46, 16, v21
    v_and_b32 v47, s55, v21
    v_and_b32 v54, 0xffff, v17
    v_and_b32 v55, s55, v17
    v_lshlrev_b32 v48, 16, v22
    v_and_b32 v49, s55, v22
    v_and_b32 v56, 0xffff, v18
    v_and_b32 v57, s55, v18
    v_lshlrev_b32 v50, 16, v23
    v_and_b32 v51, s55, v23
    v_and_b32 v58, 0xffff, v19
    v_and_b32 v59, s55, v19
    v_pk_add_f32 v[84:85], v[84:85], v[44:45] neg_lo:[0,1] neg_hi:[0,1]
    v_pk_add_f32 v[86:87], v[86:87], v[46:47] neg_lo:[0,1] neg_hi:[0,1]
    v_cvt_pk_bf16_f32 v68, v84, v85
    v_cvt_pk_bf16_f32 v69, v86, v87
    v_dot2_f32_bf16 v84, v68, v52, 0
    v_dot2_f32_bf16 v85, v68, v53, 0
    v_dot2_f32_bf16 v86, v69, v54, 0
    v_dot2_f32_bf16 v87, v69, v55, 0
    s_nop 0
    v_cvt_pk_bf16_f32 v68, v84, v85
    s_nop 0
    v_cvt_pk_bf16_f32 v69, v86, v87
    ds_write_b64 v3, v[68:69] offset:0
    s_waitcnt vmcnt(4)
    buffer_load_dwordx4 v[152:155], v1, s[40:43], s56 offen offset:1792 nt
    v_cvt_f32_i32 v88, v160
    v_cvt_f32_i32 v89, v161
    v_cvt_f32_i32 v90, v162
    v_cvt_f32_i32 v91, v163
    v_pk_add_f32 v[88:89], v[88:89], v[48:49] neg_lo:[0,1] neg_hi:[0,1]
    v_pk_add_f32 v[90:91], v[90:91], v[50:51] neg_lo:[0,1] neg_hi:[0,1]
    v_cvt_pk_bf16_f32 v70, v88, v89
    v_cvt_pk_bf16_f32 v71, v90, v91
    v_dot2_f32_bf16 v88, v70, v56, 0
    v_dot2_f32_bf16 v89, v70, v57, 0
    v_dot2_f32_bf16 v90, v71, v58, 0
    v_dot2_f32_bf16 v91, v71, v59, 0
    s_nop 0
    v_cvt_pk_bf16_f32 v70, v88, v89
    s_nop 0
    v_cvt_pk_bf16_f32 v71, v90, v91
    ds_write_b64 v3, v[70:71] offset:128
    v_cvt_pk_bf16_f32 v80, v76, v77
    v_cvt_pk_bf16_f32 v81, v78, v79
    v_lshlrev_b32 v76, 16, v80
    v_and_b32 v77, s55, v80
    v_lshlrev_b32 v78, 16, v81
    v_and_b32 v79, s55, v81
    v_mul_f32 v76, s54, v76
    v_mul_f32 v77, s54, v77
    v_mul_f32 v78, s54, v78
    v_mul_f32 v79, s54, v79
    v_cvt_pk_bf16_f32 v80, v76, v77
    v_cvt_pk_bf16_f32 v81, v78, v79
    s_mov_b64 exec, s[64:65]
    ds_write_b64 v194, v[80:81]
    s_mov_b64 exec, -1
    v_max3_f32 v10, v10, v76, v77
    v_max3_f32 v10, v10, v78, v79
    v_add_u32 v194, 128, v194
    s_waitcnt vmcnt(5)
    buffer_load_dwordx4 v[156:159], v1, s[88:91], s57 offen offset:0 nt
    v_cvt_f32_i32 v84, v164
    v_cvt_f32_i32 v85, v165
    v_cvt_f32_i32 v86, v166
    v_cvt_f32_i32 v87, v167
    v_pk_add_f32 v[84:85], v[84:85], v[44:45] neg_lo:[0,1] neg_hi:[0,1]
    v_pk_add_f32 v[86:87], v[86:87], v[46:47] neg_lo:[0,1] neg_hi:[0,1]
    v_cvt_pk_bf16_f32 v72, v84, v85
    v_cvt_pk_bf16_f32 v73, v86, v87
    v_dot2_f32_bf16 v84, v72, v52, 0
    v_dot2_f32_bf16 v85, v72, v53, 0
    v_dot2_f32_bf16 v86, v73, v54, 0
    v_dot2_f32_bf16 v87, v73, v55, 0
    s_nop 0
    v_cvt_pk_bf16_f32 v72, v84, v85
    s_nop 0
    v_cvt_pk_bf16_f32 v73, v86, v87
    ds_write_b64 v3, v[72:73] offset:272
    s_waitcnt vmcnt(4)
    buffer_load_dwordx4 v[160:163], v1, s[88:91], s57 offen offset:256 nt
    v_cvt_f32_i32 v88, v168
    v_cvt_f32_i32 v89, v169
    v_cvt_f32_i32 v90, v170
    v_cvt_f32_i32 v91, v171
    v_pk_add_f32 v[88:89], v[88:89], v[48:49] neg_lo:[0,1] neg_hi:[0,1]
    v_pk_add_f32 v[90:91], v[90:91], v[50:51] neg_lo:[0,1] neg_hi:[0,1]
    v_cvt_pk_bf16_f32 v74, v88, v89
    v_cvt_pk_bf16_f32 v75, v90, v91
    v_dot2_f32_bf16 v88, v74, v56, 0
    v_dot2_f32_bf16 v89, v74, v57, 0
    v_dot2_f32_bf16 v90, v75, v58, 0
    v_dot2_f32_bf16 v91, v75, v59, 0
    s_nop 0
    v_cvt_pk_bf16_f32 v74, v88, v89
    s_nop 0
    v_cvt_pk_bf16_f32 v75, v90, v91
    ds_write_b64 v3, v[74:75] offset:400
    s_bfe_u32 s50, s56, 262159
    s_lshl_b32 s62, s50, 8
    v_add_u32 v9, s62, v4
    ds_read_b64 v[16:17], v9 offset:17920
    ds_read_b64 v[18:19], v9 offset:18048
    ds_read_b64 v[20:21], v9 offset:22016
    ds_read_b64 v[22:23], v9 offset:22144
    s_waitcnt vmcnt(5)
    buffer_load_dwordx4 v[164:167], v1, s[88:91], s57 offen offset:512 nt
    v_cvt_f32_i32 v84, v172
    v_cvt_f32_i32 v85, v173
    v_cvt_f32_i32 v86, v174
    v_cvt_f32_i32 v87, v175
    v_pk_add_f32 v[84:85], v[84:85], v[44:45] neg_lo:[0,1] neg_hi:[0,1]
    v_pk_add_f32 v[86:87], v[86:87], v[46:47] neg_lo:[0,1] neg_hi:[0,1]
    v_cvt_pk_bf16_f32 v68, v84, v85
    v_cvt_pk_bf16_f32 v69, v86, v87
    v_dot2_f32_bf16 v84, v68, v52, 0
    v_dot2_f32_bf16 v85, v68, v53, 0
    v_dot2_f32_bf16 v86, v69, v54, 0
    v_dot2_f32_bf16 v87, v69, v55, 0
    s_nop 0
    v_cvt_pk_bf16_f32 v68, v84, v85
    s_nop 0
    v_cvt_pk_bf16_f32 v69, v86, v87
    ds_write_b64 v3, v[68:69] offset:544
    s_waitcnt vmcnt(4)
    buffer_load_dwordx4 v[168:171], v1, s[88:91], s57 offen offset:768 nt
    v_cvt_f32_i32 v88, v176
    v_cvt_f32_i32 v89, v177
    v_cvt_f32_i32 v90, v178
    v_cvt_f32_i32 v91, v179
    v_pk_add_f32 v[88:89], v[88:89], v[48:49] neg_lo:[0,1] neg_hi:[0,1]
    v_pk_add_f32 v[90:91], v[90:91], v[50:51] neg_lo:[0,1] neg_hi:[0,1]
    v_cvt_pk_bf16_f32 v70, v88, v89
    v_cvt_pk_bf16_f32 v71, v90, v91
    v_dot2_f32_bf16 v88, v70, v56, 0
    v_dot2_f32_bf16 v89, v70, v57, 0
    v_dot2_f32_bf16 v90, v71, v58, 0
    v_dot2_f32_bf16 v91, v71, v59, 0
    s_nop 0
    v_cvt_pk_bf16_f32 v70, v88, v89
    s_nop 0
    v_cvt_pk_bf16_f32 v71, v90, v91
    ds_write_b64 v3, v[70:71] offset:672
    s_waitcnt vmcnt(5)
    buffer_load_dwordx4 v[172:175], v1, s[88:91], s57 offen offset:1024 nt
    v_cvt_f32_i32 v84, v180
    v_cvt_f32_i32 v85, v181
    v_cvt_f32_i32 v86, v182
    v_cvt_f32_i32 v87, v183
    v_pk_add_f32 v[84:85], v[84:85], v[44:45] neg_lo:[0,1] neg_hi:[0,1]
    v_pk_add_f32 v[86:87], v[86:87], v[46:47] neg_lo:[0,1] neg_hi:[0,1]
    v_cvt_pk_bf16_f32 v72, v84, v85
    v_cvt_pk_bf16_f32 v73, v86, v87
    v_dot2_f32_bf16 v84, v72, v52, 0
    v_dot2_f32_bf16 v85, v72, v53, 0
    v_dot2_f32_bf16 v86, v73, v54, 0
    v_dot2_f32_bf16 v87, v73, v55, 0
    s_nop 0
    v_cvt_pk_bf16_f32 v72, v84, v85
    s_nop 0
    v_cvt_pk_bf16_f32 v73, v86, v87
    ds_write_b64 v3, v[72:73] offset:816
    s_waitcnt vmcnt(4)
    buffer_load_dwordx4 v[176:179], v1, s[88:91], s57 offen offset:1280 nt
    v_cvt_f32_i32 v88, v184
    v_cvt_f32_i32 v89, v185
    v_cvt_f32_i32 v90, v186
    v_cvt_f32_i32 v91, v187
    v_pk_add_f32 v[88:89], v[88:89], v[48:49] neg_lo:[0,1] neg_hi:[0,1]
    v_pk_add_f32 v[90:91], v[90:91], v[50:51] neg_lo:[0,1] neg_hi:[0,1]
    v_cvt_pk_bf16_f32 v74, v88, v89
    v_cvt_pk_bf16_f32 v75, v90, v91
    v_dot2_f32_bf16 v88, v74, v56, 0
    v_dot2_f32_bf16 v89, v74, v57, 0
    v_dot2_f32_bf16 v90, v75, v58, 0
    v_dot2_f32_bf16 v91, v75, v59, 0
    s_nop 0
    v_cvt_pk_bf16_f32 v74, v88, v89
    s_nop 0
    v_cvt_pk_bf16_f32 v75, v90, v91
    ds_write_b64 v3, v[74:75] offset:944
    ds_read_b128 v[92:95], v8 offset:0
    ds_read_b128 v[96:99], v8 offset:64
    ds_read_b128 v[100:103], v8 offset:128
    ds_read_b128 v[104:107], v8 offset:192
    s_add_u32 s59, s59, 1
    s_mov_b32 s56, s57
    s_mov_b64 s[40:41], s[88:89]
    s_cmp_lt_u32 s59, 16
    s_cbranch_scc1 L_kloop
    s_add_u32 s68, s68, 1799596469
    s_mov_b32 s59, 0
    s_mov_b64 vcc, 1
    s_waitcnt lgkmcnt(0)
    v_mfma_f32_16x16x32_bf16 v[76:79], v[92:95], v[28:31], 0
    v_mfma_f32_16x16x32_bf16 v[76:79], v[96:99], v[32:35], v[76:79]
    v_mfma_f32_16x16x32_bf16 v[76:79], v[100:103], v[36:39], v[76:79]
    v_mfma_f32_16x16x32_bf16 v[76:79], v[104:107], v[40:43], v[76:79]
    s_bfe_u32 s63, s2, 720904
    v_add_u32 v12, s63, v5
    ds_read_b64 v[16:17], v27
    ds_read_u16 v24, v12 offset:26112
    ds_read_u16 v25, v12 offset:28160
    v_add_u32 v27, 128, v27
    s_nop 1
    v_cvt_pk_bf16_f32 v80, v76, v77
    v_cvt_pk_bf16_f32 v81, v78, v79
    v_lshlrev_b32 v76, 16, v80
    v_and_b32 v77, s55, v80
    v_lshlrev_b32 v78, 16, v81
    v_and_b32 v79, s55, v81
    v_mul_f32 v76, s54, v76
    v_mul_f32 v77, s54, v77
    v_mul_f32 v78, s54, v78
    v_mul_f32 v79, s54, v79
    v_cvt_pk_bf16_f32 v80, v76, v77
    v_cvt_pk_bf16_f32 v81, v78, v79
    s_mov_b64 exec, s[64:65]
    ds_write_b64 v194, v[80:81]
    s_mov_b64 exec, -1
    v_max3_f32 v10, v10, v76, v77
    v_max3_f32 v10, v10, v78, v79
    v_add_u32 v194, 128, v194
    v_mov_b32 v73, v10
    s_nop 1
    v_permlane32_swap_b32 v10, v73
    v_max_f32 v10, v10, v73
    v_mov_b32 v73, v10
    s_nop 1
    v_permlane16_swap_b32 v10, v73
    v_max_f32 v10, v10, v73
    v_cvt_pk_bf16_f32 v10, v10, v10
    v_lshlrev_b32 v10, 16, v10
    v_mul_f32 v10, s53, v10
L_vloop:
    s_add_u32 s51, s59, 2
    s_lshl_b32 s57, s51, 15
    s_xor_b32 s57, s57, s2
    s_cmp_lt_u32 s51, 16
    s_cselect_b32 s57, s57, 134217728
    s_cmp_lt_u32 s59, 12
    s_cselect_b32 vcc_lo, 1, 0
    s_waitcnt lgkmcnt(0)
    v_lshlrev_b32 v76, 16, v16
    v_and_b32 v77, s55, v16
    v_lshlrev_b32 v78, 16, v17
    v_and_b32 v79, s55, v17
    v_lshlrev_b32 v13, 16, v25
    v_lshlrev_b32 v14, 16, v24
    v_fma_f32 v76, v76, s53, -v10
    v_fma_f32 v77, v77, s53, -v10
    v_fma_f32 v78, v78, s53, -v10
    v_fma_f32 v79, v79, s53, -v10
    v_mov_b32_dpp v68, v13 row_newbcast:0 row_mask:0xf bank_mask:0xf
    s_waitcnt vmcnt(13)
    s_cbranch_vccz L_w1
    s_waitcnt vmcnt(5)
L_w1:
    buffer_load_dwordx4 v[180:183], v1, s[12:15], s56 offen offset:1536 nt
    v_cvt_f32_i32 v84, v124
    v_cvt_f32_i32 v85, v125
    v_cvt_f32_i32 v86, v126
    v_cvt_f32_i32 v87, v127
    v_pk_add_f32 v[84:85], v[84:85], v[68:69] op_sel:[0,0] op_sel_hi:[1,0] neg_lo:[0,1] neg_hi:[0,1]
    v_pk_add_f32 v[86:87], v[86:87], v[68:69] op_sel:[0,0] op_sel_hi:[1,0] neg_lo:[0,1] neg_hi:[0,1]
    v_cvt_pk_bf16_f32 v108, v84, v85
    v_cvt_pk_bf16_f32 v109, v86, v87
    v_exp_f32 v76, v76
    v_exp_f32 v77, v77
    v_exp_f32 v78, v78
    v_exp_f32 v79, v79
    s_bfe_u32 s63, s56, 720904
    v_add_u32 v12, s63, v5
    ds_read_b64 v[16:17], v27
    ds_read_u16 v24, v12 offset:26112
    ds_read_u16 v25, v12 offset:28160
    v_add_u32 v27, 128, v27
    s_waitcnt vmcnt(13)
    s_cbranch_vccz L_w2
    s_waitcnt vmcnt(4)
L_w2:
    buffer_load_dwordx4 v[184:187], v1, s[12:15], s56 offen offset:1792 nt
    v_cvt_f32_i32 v88, v128
    v_cvt_f32_i32 v89, v129
    v_cvt_f32_i32 v90, v130
    v_cvt_f32_i32 v91, v131
    v_pk_add_f32 v[88:89], v[88:89], v[68:69] op_sel:[0,0] op_sel_hi:[1,0] neg_lo:[0,1] neg_hi:[0,1]
    v_pk_add_f32 v[90:91], v[90:91], v[68:69] op_sel:[0,0] op_sel_hi:[1,0] neg_lo:[0,1] neg_hi:[0,1]
    v_cvt_pk_bf16_f32 v110, v88, v89
    v_cvt_pk_bf16_f32 v111, v90, v91
    v_add_f32 v73, v76, v77
    v_add_f32 v11, v11, v78
    v_add_f32 v11, v11, v79
    v_add_f32 v11, v11, v73
    v_mul_f32_dpp v76, v14, v76 row_newbcast:0 row_mask:0xf bank_mask:0xf
    v_mul_f32_dpp v77, v14, v77 row_newbcast:1 row_mask:0xf bank_mask:0xf
    v_mul_f32_dpp v78, v14, v78 row_newbcast:2 row_mask:0xf bank_mask:0xf
    v_mul_f32_dpp v79, v14, v79 row_newbcast:3 row_mask:0xf bank_mask:0xf
    v_cvt_pk_bf16_f32 v76, v76, v76
    v_cvt_pk_bf16_f32 v77, v77, v77
    v_cvt_pk_bf16_f32 v78, v78, v78
    v_cvt_pk_bf16_f32 v79, v79, v79
    v_and_b32 v92, v6, v76
    v_and_b32 v93, v7, v76
    v_and_b32 v94, v6, v77
    v_and_b32 v95, v7, v77
    v_and_b32 v96, v6, v78
    v_and_b32 v97, v7, v78
    v_and_b32 v98, v6, v79
    v_and_b32 v99, v7, v79
    v_mfma_f32_16x16x16_bf16 v[60:63], v[92:93], v[108:109], v[60:63]
    v_mov_b32_dpp v70, v13 row_newbcast:1 row_mask:0xf bank_mask:0xf
    s_waitcnt vmcnt(13)
    s_cbranch_vccz L_w3
    s_waitcnt vmcnt(5)
L_w3:
    buffer_load_dwordx4 v[124:127], v1, s[12:15], s57 offen offset:0 nt
    v_cvt_f32_i32 v84, v132
    v_cvt_f32_i32 v85, v133
    v_cvt_f32_i32 v86, v134
    v_cvt_f32_i32 v87, v135
    v_pk_add_f32 v[84:85], v[84:85], v[70:71] op_sel:[0,0] op_sel_hi:[1,0] neg_lo:[0,1] neg_hi:[0,1]
    v_pk_add_f32 v[86:87], v[86:87], v[70:71] op_sel:[0,0] op_sel_hi:[1,0] neg_lo:[0,1] neg_hi:[0,1]
    v_cvt_pk_bf16_f32 v112, v84, v85
    v_cvt_pk_bf16_f32 v113, v86, v87
    v_mfma_f32_16x16x16_bf16 v[64:67], v[92:93], v[110:111], v[64:67]
    s_waitcnt vmcnt(13)
    s_cbranch_vccz L_w4
    s_waitcnt vmcnt(4)
L_w4:
    buffer_load_dwordx4 v[128:131], v1, s[12:15], s57 offen offset:256 nt
    v_cvt_f32_i32 v88, v136
    v_cvt_f32_i32 v89, v137
    v_cvt_f32_i32 v90, v138
    v_cvt_f32_i32 v91, v139
    v_pk_add_f32 v[88:89], v[88:89], v[70:71] op_sel:[0,0] op_sel_hi:[1,0] neg_lo:[0,1] neg_hi:[0,1]
    v_pk_add_f32 v[90:91], v[90:91], v[70:71] op_sel:[0,0] op_sel_hi:[1,0] neg_lo:[0,1] neg_hi:[0,1]
    v_cvt_pk_bf16_f32 v114, v88, v89
    v_cvt_pk_bf16_f32 v115, v90, v91
    v_mfma_f32_16x16x16_bf16 v[60:63], v[94:95], v[112:113], v[60:63]
    v_mov_b32_dpp v68, v13 row_newbcast:2 row_mask:0xf bank_mask:0xf
    s_waitcnt vmcnt(13)
    s_cbranch_vccz L_w5
    s_waitcnt vmcnt(5)
L_w5:
    buffer_load_dwordx4 v[132:135], v1, s[12:15], s57 offen offset:512 nt
    v_cvt_f32_i32 v84, v140
    v_cvt_f32_i32 v85, v141
    v_cvt_f32_i32 v86, v142
    v_cvt_f32_i32 v87, v143
    v_pk_add_f32 v[84:85], v[84:85], v[68:69] op_sel:[0,0] op_sel_hi:[1,0] neg_lo:[0,1] neg_hi:[0,1]
    v_pk_add_f32 v[86:87], v[86:87], v[68:69] op_sel:[0,0] op_sel_hi:[1,0] neg_lo:[0,1] neg_hi:[0,1]
    v_cvt_pk_bf16_f32 v116, v84, v85
    v_cvt_pk_bf16_f32 v117, v86, v87
    v_mfma_f32_16x16x16_bf16 v[64:67], v[94:95], v[114:115], v[64:67]
    s_waitcnt vmcnt(13)
    s_cbranch_vccz L_w6
    s_waitcnt vmcnt(4)
L_w6:
    buffer_load_dwordx4 v[136:139], v1, s[12:15], s57 offen offset:768 nt
    v_cvt_f32_i32 v88, v144
    v_cvt_f32_i32 v89, v145
    v_cvt_f32_i32 v90, v146
    v_cvt_f32_i32 v91, v147
    v_pk_add_f32 v[88:89], v[88:89], v[68:69] op_sel:[0,0] op_sel_hi:[1,0] neg_lo:[0,1] neg_hi:[0,1]
    v_pk_add_f32 v[90:91], v[90:91], v[68:69] op_sel:[0,0] op_sel_hi:[1,0] neg_lo:[0,1] neg_hi:[0,1]
    v_cvt_pk_bf16_f32 v118, v88, v89
    v_cvt_pk_bf16_f32 v119, v90, v91
    v_mfma_f32_16x16x16_bf16 v[60:63], v[96:97], v[116:117], v[60:63]
    v_mov_b32_dpp v70, v13 row_newbcast:3 row_mask:0xf bank_mask:0xf
    s_waitcnt vmcnt(13)
    s_cbranch_vccz L_w7
    s_waitcnt vmcnt(5)
L_w7:
    buffer_load_dwordx4 v[140:143], v1, s[12:15], s57 offen offset:1024 nt
    v_cvt_f32_i32 v84, v148
    v_cvt_f32_i32 v85, v149
    v_cvt_f32_i32 v86, v150
    v_cvt_f32_i32 v87, v151
    v_pk_add_f32 v[84:85], v[84:85], v[70:71] op_sel:[0,0] op_sel_hi:[1,0] neg_lo:[0,1] neg_hi:[0,1]
    v_pk_add_f32 v[86:87], v[86:87], v[70:71] op_sel:[0,0] op_sel_hi:[1,0] neg_lo:[0,1] neg_hi:[0,1]
    v_cvt_pk_bf16_f32 v120, v84, v85
    v_cvt_pk_bf16_f32 v121, v86, v87
    v_mfma_f32_16x16x16_bf16 v[64:67], v[96:97], v[118:119], v[64:67]
    s_waitcnt vmcnt(13)
    s_cbranch_vccz L_w8
    s_waitcnt vmcnt(4)
L_w8:
    buffer_load_dwordx4 v[144:147], v1, s[12:15], s57 offen offset:1280 nt
    v_cvt_f32_i32 v88, v152
    v_cvt_f32_i32 v89, v153
    v_cvt_f32_i32 v90, v154
    v_cvt_f32_i32 v91, v155
    v_pk_add_f32 v[88:89], v[88:89], v[70:71] op_sel:[0,0] op_sel_hi:[1,0] neg_lo:[0,1] neg_hi:[0,1]
    v_pk_add_f32 v[90:91], v[90:91], v[70:71] op_sel:[0,0] op_sel_hi:[1,0] neg_lo:[0,1] neg_hi:[0,1]
    v_cvt_pk_bf16_f32 v122, v88, v89
    v_cvt_pk_bf16_f32 v123, v90, v91
    v_mfma_f32_16x16x16_bf16 v[60:63], v[98:99], v[120:121], v[60:63]
    s_nop 0
    v_mfma_f32_16x16x16_bf16 v[64:67], v[98:99], v[122:123], v[64:67]
    s_add_u32 s59, s59, 1
    s_mov_b32 s56, s57
    s_add_u32 s51, s59, 2
    s_lshl_b32 s57, s51, 15
    s_xor_b32 s57, s57, s2
    s_cmp_lt_u32 s51, 16
    s_cselect_b32 s57, s57, 134217728
    s_cmp_lt_u32 s59, 12
    s_cselect_b32 vcc_lo, 1, 0
    s_waitcnt lgkmcnt(0)
    v_lshlrev_b32 v76, 16, v16
    v_and_b32 v77, s55, v16
    v_lshlrev_b32 v78, 16, v17
    v_and_b32 v79, s55, v17
    v_lshlrev_b32 v13, 16, v25
    v_lshlrev_b32 v14, 16, v24
    v_fma_f32 v76, v76, s53, -v10
    v_fma_f32 v77, v77, s53, -v10
    v_fma_f32 v78, v78, s53, -v10
    v_fma_f32 v79, v79, s53, -v10
    v_mov_b32_dpp v68, v13 row_newbcast:0 row_mask:0xf bank_mask:0xf
    s_waitcnt vmcnt(13)
    s_cbranch_vccz L_w9
    s_waitcnt vmcnt(5)
L_w9:
    buffer_load_dwordx4 v[148:151], v1, s[12:15], s56 offen offset:1536 nt
    v_cvt_f32_i32 v84, v156
    v_cvt_f32_i32 v85, v157
    v_cvt_f32_i32 v86, v158
    v_cvt_f32_i32 v87, v159
    v_pk_add_f32 v[84:85], v[84:85], v[68:69] op_sel:[0,0] op_sel_hi:[1,0] neg_lo:[0,1] neg_hi:[0,1]
    v_pk_add_f32 v[86:87], v[86:87], v[68:69] op_sel:[0,0] op_sel_hi:[1,0] neg_lo:[0,1] neg_hi:[0,1]
    v_cvt_pk_bf16_f32 v108, v84, v85
    v_cvt_pk_bf16_f32 v109, v86, v87
    v_exp_f32 v76, v76
    v_exp_f32 v77, v77
    v_exp_f32 v78, v78
    v_exp_f32 v79, v79
    s_bfe_u32 s63, s56, 720904
    v_add_u32 v12, s63, v5
    ds_read_b64 v[16:17], v27
    ds_read_u16 v24, v12 offset:26112
    ds_read_u16 v25, v12 offset:28160
    v_add_u32 v27, 128, v27
    s_waitcnt vmcnt(13)
    s_cbranch_vccz L_w10
    s_waitcnt vmcnt(4)
L_w10:
    buffer_load_dwordx4 v[152:155], v1, s[12:15], s56 offen offset:1792 nt
    v_cvt_f32_i32 v88, v160
    v_cvt_f32_i32 v89, v161
    v_cvt_f32_i32 v90, v162
    v_cvt_f32_i32 v91, v163
    v_pk_add_f32 v[88:89], v[88:89], v[68:69] op_sel:[0,0] op_sel_hi:[1,0] neg_lo:[0,1] neg_hi:[0,1]
    v_pk_add_f32 v[90:91], v[90:91], v[68:69] op_sel:[0,0] op_sel_hi:[1,0] neg_lo:[0,1] neg_hi:[0,1]
    v_cvt_pk_bf16_f32 v110, v88, v89
    v_cvt_pk_bf16_f32 v111, v90, v91
    v_add_f32 v73, v76, v77
    v_add_f32 v11, v11, v78
    v_add_f32 v11, v11, v79
    v_add_f32 v11, v11, v73
    v_mul_f32_dpp v76, v14, v76 row_newbcast:0 row_mask:0xf bank_mask:0xf
    v_mul_f32_dpp v77, v14, v77 row_newbcast:1 row_mask:0xf bank_mask:0xf
    v_mul_f32_dpp v78, v14, v78 row_newbcast:2 row_mask:0xf bank_mask:0xf
    v_mul_f32_dpp v79, v14, v79 row_newbcast:3 row_mask:0xf bank_mask:0xf
    v_cvt_pk_bf16_f32 v76, v76, v76
    v_cvt_pk_bf16_f32 v77, v77, v77
    v_cvt_pk_bf16_f32 v78, v78, v78
    v_cvt_pk_bf16_f32 v79, v79, v79
    v_and_b32 v92, v6, v76
    v_and_b32 v93, v7, v76
    v_and_b32 v94, v6, v77
    v_and_b32 v95, v7, v77
    v_and_b32 v96, v6, v78
    v_and_b32 v97, v7, v78
    v_and_b32 v98, v6, v79
    v_and_b32 v99, v7, v79
    v_mfma_f32_16x16x16_bf16 v[60:63], v[92:93], v[108:109], v[60:63]
    v_mov_b32_dpp v70, v13 row_newbcast:1 row_mask:0xf bank_mask:0xf
    s_waitcnt vmcnt(13)
    s_cbranch_vccz L_w11
    s_waitcnt vmcnt(5)
L_w11:
    buffer_load_dwordx4 v[156:159], v1, s[12:15], s57 offen offset:0 nt
    v_cvt_f32_i32 v84, v164
    v_cvt_f32_i32 v85, v165
    v_cvt_f32_i32 v86, v166
    v_cvt_f32_i32 v87, v167
    v_pk_add_f32 v[84:85], v[84:85], v[70:71] op_sel:[0,0] op_sel_hi:[1,0] neg_lo:[0,1] neg_hi:[0,1]
    v_pk_add_f32 v[86:87], v[86:87], v[70:71] op_sel:[0,0] op_sel_hi:[1,0] neg_lo:[0,1] neg_hi:[0,1]
    v_cvt_pk_bf16_f32 v112, v84, v85
    v_cvt_pk_bf16_f32 v113, v86, v87
    v_mfma_f32_16x16x16_bf16 v[64:67], v[92:93], v[110:111], v[64:67]
    s_waitcnt vmcnt(13)
    s_cbranch_vccz L_w12
    s_waitcnt vmcnt(4)
L_w12:
    buffer_load_dwordx4 v[160:163], v1, s[12:15], s57 offen offset:256 nt
    v_cvt_f32_i32 v88, v168
    v_cvt_f32_i32 v89, v169
    v_cvt_f32_i32 v90, v170
    v_cvt_f32_i32 v91, v171
    v_pk_add_f32 v[88:89], v[88:89], v[70:71] op_sel:[0,0] op_sel_hi:[1,0] neg_lo:[0,1] neg_hi:[0,1]
    v_pk_add_f32 v[90:91], v[90:91], v[70:71] op_sel:[0,0] op_sel_hi:[1,0] neg_lo:[0,1] neg_hi:[0,1]
    v_cvt_pk_bf16_f32 v114, v88, v89
    v_cvt_pk_bf16_f32 v115, v90, v91
    v_mfma_f32_16x16x16_bf16 v[60:63], v[94:95], v[112:113], v[60:63]
    v_mov_b32_dpp v68, v13 row_newbcast:2 row_mask:0xf bank_mask:0xf
    s_waitcnt vmcnt(13)
    s_cbranch_vccz L_w13
    s_waitcnt vmcnt(5)
L_w13:
    buffer_load_dwordx4 v[164:167], v1, s[12:15], s57 offen offset:512 nt
    v_cvt_f32_i32 v84, v172
    v_cvt_f32_i32 v85, v173
    v_cvt_f32_i32 v86, v174
    v_cvt_f32_i32 v87, v175
    v_pk_add_f32 v[84:85], v[84:85], v[68:69] op_sel:[0,0] op_sel_hi:[1,0] neg_lo:[0,1] neg_hi:[0,1]
    v_pk_add_f32 v[86:87], v[86:87], v[68:69] op_sel:[0,0] op_sel_hi:[1,0] neg_lo:[0,1] neg_hi:[0,1]
    v_cvt_pk_bf16_f32 v116, v84, v85
    v_cvt_pk_bf16_f32 v117, v86, v87
    v_mfma_f32_16x16x16_bf16 v[64:67], v[94:95], v[114:115], v[64:67]
    s_waitcnt vmcnt(13)
    s_cbranch_vccz L_w14
    s_waitcnt vmcnt(4)
L_w14:
    buffer_load_dwordx4 v[168:171], v1, s[12:15], s57 offen offset:768 nt
    v_cvt_f32_i32 v88, v176
    v_cvt_f32_i32 v89, v177
    v_cvt_f32_i32 v90, v178
    v_cvt_f32_i32 v91, v179
    v_pk_add_f32 v[88:89], v[88:89], v[68:69] op_sel:[0,0] op_sel_hi:[1,0] neg_lo:[0,1] neg_hi:[0,1]
    v_pk_add_f32 v[90:91], v[90:91], v[68:69] op_sel:[0,0] op_sel_hi:[1,0] neg_lo:[0,1] neg_hi:[0,1]
    v_cvt_pk_bf16_f32 v118, v88, v89
    v_cvt_pk_bf16_f32 v119, v90, v91
    v_mfma_f32_16x16x16_bf16 v[60:63], v[96:97], v[116:117], v[60:63]
    v_mov_b32_dpp v70, v13 row_newbcast:3 row_mask:0xf bank_mask:0xf
    s_waitcnt vmcnt(13)
    s_cbranch_vccz L_w15
    s_waitcnt vmcnt(5)
L_w15:
    buffer_load_dwordx4 v[172:175], v1, s[12:15], s57 offen offset:1024 nt
    v_cvt_f32_i32 v84, v180
    v_cvt_f32_i32 v85, v181
    v_cvt_f32_i32 v86, v182
    v_cvt_f32_i32 v87, v183
    v_pk_add_f32 v[84:85], v[84:85], v[70:71] op_sel:[0,0] op_sel_hi:[1,0] neg_lo:[0,1] neg_hi:[0,1]
    v_pk_add_f32 v[86:87], v[86:87], v[70:71] op_sel:[0,0] op_sel_hi:[1,0] neg_lo:[0,1] neg_hi:[0,1]
    v_cvt_pk_bf16_f32 v120, v84, v85
    v_cvt_pk_bf16_f32 v121, v86, v87
    v_mfma_f32_16x16x16_bf16 v[64:67], v[96:97], v[118:119], v[64:67]
    s_waitcnt vmcnt(13)
    s_cbranch_vccz L_w16
    s_waitcnt vmcnt(4)
L_w16:
    buffer_load_dwordx4 v[176:179], v1, s[12:15], s57 offen offset:1280 nt
    v_cvt_f32_i32 v88, v184
    v_cvt_f32_i32 v89, v185
    v_cvt_f32_i32 v90, v186
    v_cvt_f32_i32 v91, v187
    v_pk_add_f32 v[88:89], v[88:89], v[70:71] op_sel:[0,0] op_sel_hi:[1,0] neg_lo:[0,1] neg_hi:[0,1]
    v_pk_add_f32 v[90:91], v[90:91], v[70:71] op_sel:[0,0] op_sel_hi:[1,0] neg_lo:[0,1] neg_hi:[0,1]
    v_cvt_pk_bf16_f32 v122, v88, v89
    v_cvt_pk_bf16_f32 v123, v90, v91
    v_mfma_f32_16x16x16_bf16 v[60:63], v[98:99], v[120:121], v[60:63]
    s_nop 0
    v_mfma_f32_16x16x16_bf16 v[64:67], v[98:99], v[122:123], v[64:67]
    s_add_u32 s59, s59, 1
    s_mov_b32 s56, s57
    s_cmp_lt_u32 s59, 16
    s_cbranch_scc1 L_vloop
    v_mov_b32 v68, v11
    s_nop 1
    v_permlane32_swap_b32 v11, v68
    v_add_f32 v11, v11, v68
    v_mov_b32 v68, v11
    s_nop 1
    v_permlane16_swap_b32 v11, v68
    v_add_f32 v11, v11, v68
    ds_write_b128 v188, v[60:63]
    ds_write_b128 v188, v[64:67] offset:256
    s_mov_b64 exec, 0x1111
    ds_write_b64 v189, v[10:11]
    s_mov_b64 exec, -1
    s_waitcnt lgkmcnt(0)
    s_barrier
    ds_read_b128 v[36:39], v191
    ds_read_b128 v[40:43], v191 offset:16
    ds_read_b64 v[28:29], v190 offset:0
    ds_read_b64 v[30:31], v190 offset:4352
    ds_read_b64 v[32:33], v190 offset:8704
    ds_read_b64 v[34:35], v190 offset:13056
    s_cmp_lg_u32 s61, 0
    s_cbranch_scc1 L_red
    buffer_load_dwordx4 v[124:127], v15, s[44:47], s77 offen sc1
    buffer_load_dwordx4 v[128:131], v15, s[44:47], s78 offen sc1
    buffer_load_dwordx4 v[132:135], v15, s[44:47], s79 offen sc1
    buffer_load_dwordx4 v[136:139], v15, s[44:47], s80 offen sc1
    buffer_load_dwordx4 v[140:143], v15, s[44:47], s81 offen sc1
    buffer_load_dwordx4 v[144:147], v15, s[44:47], s82 offen sc1
    buffer_load_dwordx4 v[148:151], v15, s[44:47], s83 offen sc1
L_red:
    s_waitcnt lgkmcnt(4)
    v_max3_f32 v78, v36, v38, v40
    v_max_f32 v78, v78, v42
    v_sub_f32 v36, v36, v78
    v_sub_f32 v38, v38, v78
    v_sub_f32 v40, v40, v78
    v_sub_f32 v42, v42, v78
    v_exp_f32 v36, v36
    v_exp_f32 v38, v38
    v_exp_f32 v40, v40
    v_exp_f32 v42, v42
    s_mov_b32 vcc_lo, 0xaaaaaaaa
    s_mov_b32 vcc_hi, 0xaaaaaaaa
    s_waitcnt lgkmcnt(0)
    v_mul_f32 v79, v36, v37
    v_mul_f32 v76, v36, v28
    v_mul_f32 v77, v36, v29
    v_fmac_f32 v79, v38, v39
    v_fmac_f32 v76, v38, v30
    v_fmac_f32 v77, v38, v31
    v_fmac_f32 v79, v40, v41
    v_fmac_f32 v76, v40, v32
    v_fmac_f32 v77, v40, v33
    v_fmac_f32 v79, v42, v43
    v_fmac_f32 v76, v42, v34
    v_fmac_f32 v77, v42, v35
    s_cmp_eq_u32 s61, 0
    s_cbranch_scc1 L_poll0
    v_cndmask_b32 v78, v78, v79, vcc
    v_mov_b32 v79, s68
    buffer_store_dwordx4 v[76:79], v15, s[44:47], s70 offen sc1
    s_branch L_end
L_poll0:
L_ploop:
    buffer_load_dwordx4 v[156:159], v15, s[44:47], s77 offen sc1
    buffer_load_dwordx4 v[160:163], v15, s[44:47], s78 offen sc1
    buffer_load_dwordx4 v[164:167], v15, s[44:47], s79 offen sc1
    buffer_load_dwordx4 v[168:171], v15, s[44:47], s80 offen sc1
    buffer_load_dwordx4 v[172:175], v15, s[44:47], s81 offen sc1
    buffer_load_dwordx4 v[176:179], v15, s[44:47], s82 offen sc1
    buffer_load_dwordx4 v[180:183], v15, s[44:47], s83 offen sc1
    s_waitcnt vmcnt(13)
    v_cmp_ne_u32 vcc, s68, v127
    v_max_f32_dpp v74, v126, v78 quad_perm:[0,0,2,2] row_mask:0xf bank_mask:0xf
    s_cmp_ge_u32 s77, 1114112
    s_cbranch_scc1 L_ska1
    v_sub_f32 v72, v78, v74
    v_sub_f32_dpp v73, v126, v74 quad_perm:[0,0,2,2] row_mask:0xf bank_mask:0xf
    s_cbranch_vccnz L_ska1
    v_exp_f32 v72, v72
    v_exp_f32 v73, v73
    v_mov_b32 v78, v74
    s_mov_b32 s77, 1114112
    s_sub_u32 s76, s76, 1
    v_mul_f32 v76, v76, v72
    v_mul_f32 v77, v77, v72
    v_mul_f32 v79, v79, v72
    v_fmac_f32 v76, v124, v73
    v_fmac_f32 v77, v125, v73
    v_fmac_f32_dpp v79, v126, v73 quad_perm:[1,1,3,3] row_mask:0xf bank_mask:0xf
    s_cmp_eq_u32 s76, 0
    s_cbranch_scc1 L_done
L_ska1:
    s_nop 0
    s_waitcnt vmcnt(12)
    v_cmp_ne_u32 vcc, s68, v131
    v_max_f32_dpp v74, v130, v78 quad_perm:[0,0,2,2] row_mask:0xf bank_mask:0xf
    s_cmp_ge_u32 s78, 1114112
    s_cbranch_scc1 L_ska2
    v_sub_f32 v72, v78, v74
    v_sub_f32_dpp v73, v130, v74 quad_perm:[0,0,2,2] row_mask:0xf bank_mask:0xf
    s_cbranch_vccnz L_ska2
    v_exp_f32 v72, v72
    v_exp_f32 v73, v73
    v_mov_b32 v78, v74
    s_mov_b32 s78, 1114112
    s_sub_u32 s76, s76, 1
    v_mul_f32 v76, v76, v72
    v_mul_f32 v77, v77, v72
    v_mul_f32 v79, v79, v72
    v_fmac_f32 v76, v128, v73
    v_fmac_f32 v77, v129, v73
    v_fmac_f32_dpp v79, v130, v73 quad_perm:[1,1,3,3] row_mask:0xf bank_mask:0xf
    s_cmp_eq_u32 s76, 0
    s_cbranch_scc1 L_done
L_ska2:
    s_nop 0
    s_waitcnt vmcnt(11)
    v_cmp_ne_u32 vcc, s68, v135
    v_max_f32_dpp v74, v134, v78 quad_perm:[0,0,2,2] row_mask:0xf bank_mask:0xf
    s_cmp_ge_u32 s79, 1114112
    s_cbranch_scc1 L_ska3
    v_sub_f32 v72, v78, v74
    v_sub_f32_dpp v73, v134, v74 quad_perm:[0,0,2,2] row_mask:0xf bank_mask:0xf
    s_cbranch_vccnz L_ska3
    v_exp_f32 v72, v72
    v_exp_f32 v73, v73
    v_mov_b32 v78, v74
    s_mov_b32 s79, 1114112
    s_sub_u32 s76, s76, 1
    v_mul_f32 v76, v76, v72
    v_mul_f32 v77, v77, v72
    v_mul_f32 v79, v79, v72
    v_fmac_f32 v76, v132, v73
    v_fmac_f32 v77, v133, v73
    v_fmac_f32_dpp v79, v134, v73 quad_perm:[1,1,3,3] row_mask:0xf bank_mask:0xf
    s_cmp_eq_u32 s76, 0
    s_cbranch_scc1 L_done
L_ska3:
    s_nop 0
    s_waitcnt vmcnt(10)
    v_cmp_ne_u32 vcc, s68, v139
    v_max_f32_dpp v74, v138, v78 quad_perm:[0,0,2,2] row_mask:0xf bank_mask:0xf
    s_cmp_ge_u32 s80, 1114112
    s_cbranch_scc1 L_ska4
    v_sub_f32 v72, v78, v74
    v_sub_f32_dpp v73, v138, v74 quad_perm:[0,0,2,2] row_mask:0xf bank_mask:0xf
    s_cbranch_vccnz L_ska4
    v_exp_f32 v72, v72
    v_exp_f32 v73, v73
    v_mov_b32 v78, v74
    s_mov_b32 s80, 1114112
    s_sub_u32 s76, s76, 1
    v_mul_f32 v76, v76, v72
    v_mul_f32 v77, v77, v72
    v_mul_f32 v79, v79, v72
    v_fmac_f32 v76, v136, v73
    v_fmac_f32 v77, v137, v73
    v_fmac_f32_dpp v79, v138, v73 quad_perm:[1,1,3,3] row_mask:0xf bank_mask:0xf
    s_cmp_eq_u32 s76, 0
    s_cbranch_scc1 L_done
L_ska4:
    s_nop 0
    s_waitcnt vmcnt(9)
    v_cmp_ne_u32 vcc, s68, v143
    v_max_f32_dpp v74, v142, v78 quad_perm:[0,0,2,2] row_mask:0xf bank_mask:0xf
    s_cmp_ge_u32 s81, 1114112
    s_cbranch_scc1 L_ska5
    v_sub_f32 v72, v78, v74
    v_sub_f32_dpp v73, v142, v74 quad_perm:[0,0,2,2] row_mask:0xf bank_mask:0xf
    s_cbranch_vccnz L_ska5
    v_exp_f32 v72, v72
    v_exp_f32 v73, v73
    v_mov_b32 v78, v74
    s_mov_b32 s81, 1114112
    s_sub_u32 s76, s76, 1
    v_mul_f32 v76, v76, v72
    v_mul_f32 v77, v77, v72
    v_mul_f32 v79, v79, v72
    v_fmac_f32 v76, v140, v73
    v_fmac_f32 v77, v141, v73
    v_fmac_f32_dpp v79, v142, v73 quad_perm:[1,1,3,3] row_mask:0xf bank_mask:0xf
    s_cmp_eq_u32 s76, 0
    s_cbranch_scc1 L_done
L_ska5:
    s_nop 0
    s_waitcnt vmcnt(8)
    v_cmp_ne_u32 vcc, s68, v147
    v_max_f32_dpp v74, v146, v78 quad_perm:[0,0,2,2] row_mask:0xf bank_mask:0xf
    s_cmp_ge_u32 s82, 1114112
    s_cbranch_scc1 L_ska6
    v_sub_f32 v72, v78, v74
    v_sub_f32_dpp v73, v146, v74 quad_perm:[0,0,2,2] row_mask:0xf bank_mask:0xf
    s_cbranch_vccnz L_ska6
    v_exp_f32 v72, v72
    v_exp_f32 v73, v73
    v_mov_b32 v78, v74
    s_mov_b32 s82, 1114112
    s_sub_u32 s76, s76, 1
    v_mul_f32 v76, v76, v72
    v_mul_f32 v77, v77, v72
    v_mul_f32 v79, v79, v72
    v_fmac_f32 v76, v144, v73
    v_fmac_f32 v77, v145, v73
    v_fmac_f32_dpp v79, v146, v73 quad_perm:[1,1,3,3] row_mask:0xf bank_mask:0xf
    s_cmp_eq_u32 s76, 0
    s_cbranch_scc1 L_done
L_ska6:
    s_nop 0
    s_waitcnt vmcnt(7)
    v_cmp_ne_u32 vcc, s68, v151
    v_max_f32_dpp v74, v150, v78 quad_perm:[0,0,2,2] row_mask:0xf bank_mask:0xf
    s_cmp_ge_u32 s83, 1114112
    s_cbranch_scc1 L_ska7
    v_sub_f32 v72, v78, v74
    v_sub_f32_dpp v73, v150, v74 quad_perm:[0,0,2,2] row_mask:0xf bank_mask:0xf
    s_cbranch_vccnz L_ska7
    v_exp_f32 v72, v72
    v_exp_f32 v73, v73
    v_mov_b32 v78, v74
    s_mov_b32 s83, 1114112
    s_sub_u32 s76, s76, 1
    v_mul_f32 v76, v76, v72
    v_mul_f32 v77, v77, v72
    v_mul_f32 v79, v79, v72
    v_fmac_f32 v76, v148, v73
    v_fmac_f32 v77, v149, v73
    v_fmac_f32_dpp v79, v150, v73 quad_perm:[1,1,3,3] row_mask:0xf bank_mask:0xf
    s_cmp_eq_u32 s76, 0
    s_cbranch_scc1 L_done
L_ska7:
    s_nop 0
    buffer_load_dwordx4 v[124:127], v15, s[44:47], s77 offen sc1
    buffer_load_dwordx4 v[128:131], v15, s[44:47], s78 offen sc1
    buffer_load_dwordx4 v[132:135], v15, s[44:47], s79 offen sc1
    buffer_load_dwordx4 v[136:139], v15, s[44:47], s80 offen sc1
    buffer_load_dwordx4 v[140:143], v15, s[44:47], s81 offen sc1
    buffer_load_dwordx4 v[144:147], v15, s[44:47], s82 offen sc1
    buffer_load_dwordx4 v[148:151], v15, s[44:47], s83 offen sc1
    s_waitcnt vmcnt(13)
    v_cmp_ne_u32 vcc, s68, v159
    v_max_f32_dpp v74, v158, v78 quad_perm:[0,0,2,2] row_mask:0xf bank_mask:0xf
    s_cmp_ge_u32 s77, 1114112
    s_cbranch_scc1 L_skb1
    v_sub_f32 v72, v78, v74
    v_sub_f32_dpp v73, v158, v74 quad_perm:[0,0,2,2] row_mask:0xf bank_mask:0xf
    s_cbranch_vccnz L_skb1
    v_exp_f32 v72, v72
    v_exp_f32 v73, v73
    v_mov_b32 v78, v74
    s_mov_b32 s77, 1114112
    s_sub_u32 s76, s76, 1
    v_mul_f32 v76, v76, v72
    v_mul_f32 v77, v77, v72
    v_mul_f32 v79, v79, v72
    v_fmac_f32 v76, v156, v73
    v_fmac_f32 v77, v157, v73
    v_fmac_f32_dpp v79, v158, v73 quad_perm:[1,1,3,3] row_mask:0xf bank_mask:0xf
    s_cmp_eq_u32 s76, 0
    s_cbranch_scc1 L_done
L_skb1:
    s_nop 0
    s_waitcnt vmcnt(12)
    v_cmp_ne_u32 vcc, s68, v163
    v_max_f32_dpp v74, v162, v78 quad_perm:[0,0,2,2] row_mask:0xf bank_mask:0xf
    s_cmp_ge_u32 s78, 1114112
    s_cbranch_scc1 L_skb2
    v_sub_f32 v72, v78, v74
    v_sub_f32_dpp v73, v162, v74 quad_perm:[0,0,2,2] row_mask:0xf bank_mask:0xf
    s_cbranch_vccnz L_skb2
    v_exp_f32 v72, v72
    v_exp_f32 v73, v73
    v_mov_b32 v78, v74
    s_mov_b32 s78, 1114112
    s_sub_u32 s76, s76, 1
    v_mul_f32 v76, v76, v72
    v_mul_f32 v77, v77, v72
    v_mul_f32 v79, v79, v72
    v_fmac_f32 v76, v160, v73
    v_fmac_f32 v77, v161, v73
    v_fmac_f32_dpp v79, v162, v73 quad_perm:[1,1,3,3] row_mask:0xf bank_mask:0xf
    s_cmp_eq_u32 s76, 0
    s_cbranch_scc1 L_done
L_skb2:
    s_nop 0
    s_waitcnt vmcnt(11)
    v_cmp_ne_u32 vcc, s68, v167
    v_max_f32_dpp v74, v166, v78 quad_perm:[0,0,2,2] row_mask:0xf bank_mask:0xf
    s_cmp_ge_u32 s79, 1114112
    s_cbranch_scc1 L_skb3
    v_sub_f32 v72, v78, v74
    v_sub_f32_dpp v73, v166, v74 quad_perm:[0,0,2,2] row_mask:0xf bank_mask:0xf
    s_cbranch_vccnz L_skb3
    v_exp_f32 v72, v72
    v_exp_f32 v73, v73
    v_mov_b32 v78, v74
    s_mov_b32 s79, 1114112
    s_sub_u32 s76, s76, 1
    v_mul_f32 v76, v76, v72
    v_mul_f32 v77, v77, v72
    v_mul_f32 v79, v79, v72
    v_fmac_f32 v76, v164, v73
    v_fmac_f32 v77, v165, v73
    v_fmac_f32_dpp v79, v166, v73 quad_perm:[1,1,3,3] row_mask:0xf bank_mask:0xf
    s_cmp_eq_u32 s76, 0
    s_cbranch_scc1 L_done
L_skb3:
    s_nop 0
    s_waitcnt vmcnt(10)
    v_cmp_ne_u32 vcc, s68, v171
    v_max_f32_dpp v74, v170, v78 quad_perm:[0,0,2,2] row_mask:0xf bank_mask:0xf
    s_cmp_ge_u32 s80, 1114112
    s_cbranch_scc1 L_skb4
    v_sub_f32 v72, v78, v74
    v_sub_f32_dpp v73, v170, v74 quad_perm:[0,0,2,2] row_mask:0xf bank_mask:0xf
    s_cbranch_vccnz L_skb4
    v_exp_f32 v72, v72
    v_exp_f32 v73, v73
    v_mov_b32 v78, v74
    s_mov_b32 s80, 1114112
    s_sub_u32 s76, s76, 1
    v_mul_f32 v76, v76, v72
    v_mul_f32 v77, v77, v72
    v_mul_f32 v79, v79, v72
    v_fmac_f32 v76, v168, v73
    v_fmac_f32 v77, v169, v73
    v_fmac_f32_dpp v79, v170, v73 quad_perm:[1,1,3,3] row_mask:0xf bank_mask:0xf
    s_cmp_eq_u32 s76, 0
    s_cbranch_scc1 L_done
L_skb4:
    s_nop 0
    s_waitcnt vmcnt(9)
    v_cmp_ne_u32 vcc, s68, v175
    v_max_f32_dpp v74, v174, v78 quad_perm:[0,0,2,2] row_mask:0xf bank_mask:0xf
    s_cmp_ge_u32 s81, 1114112
    s_cbranch_scc1 L_skb5
    v_sub_f32 v72, v78, v74
    v_sub_f32_dpp v73, v174, v74 quad_perm:[0,0,2,2] row_mask:0xf bank_mask:0xf
    s_cbranch_vccnz L_skb5
    v_exp_f32 v72, v72
    v_exp_f32 v73, v73
    v_mov_b32 v78, v74
    s_mov_b32 s81, 1114112
    s_sub_u32 s76, s76, 1
    v_mul_f32 v76, v76, v72
    v_mul_f32 v77, v77, v72
    v_mul_f32 v79, v79, v72
    v_fmac_f32 v76, v172, v73
    v_fmac_f32 v77, v173, v73
    v_fmac_f32_dpp v79, v174, v73 quad_perm:[1,1,3,3] row_mask:0xf bank_mask:0xf
    s_cmp_eq_u32 s76, 0
    s_cbranch_scc1 L_done
L_skb5:
    s_nop 0
    s_waitcnt vmcnt(8)
    v_cmp_ne_u32 vcc, s68, v179
    v_max_f32_dpp v74, v178, v78 quad_perm:[0,0,2,2] row_mask:0xf bank_mask:0xf
    s_cmp_ge_u32 s82, 1114112
    s_cbranch_scc1 L_skb6
    v_sub_f32 v72, v78, v74
    v_sub_f32_dpp v73, v178, v74 quad_perm:[0,0,2,2] row_mask:0xf bank_mask:0xf
    s_cbranch_vccnz L_skb6
    v_exp_f32 v72, v72
    v_exp_f32 v73, v73
    v_mov_b32 v78, v74
    s_mov_b32 s82, 1114112
    s_sub_u32 s76, s76, 1
    v_mul_f32 v76, v76, v72
    v_mul_f32 v77, v77, v72
    v_mul_f32 v79, v79, v72
    v_fmac_f32 v76, v176, v73
    v_fmac_f32 v77, v177, v73
    v_fmac_f32_dpp v79, v178, v73 quad_perm:[1,1,3,3] row_mask:0xf bank_mask:0xf
    s_cmp_eq_u32 s76, 0
    s_cbranch_scc1 L_done
L_skb6:
    s_nop 0
    s_waitcnt vmcnt(7)
    v_cmp_ne_u32 vcc, s68, v183
    v_max_f32_dpp v74, v182, v78 quad_perm:[0,0,2,2] row_mask:0xf bank_mask:0xf
    s_cmp_ge_u32 s83, 1114112
    s_cbranch_scc1 L_skb7
    v_sub_f32 v72, v78, v74
    v_sub_f32_dpp v73, v182, v74 quad_perm:[0,0,2,2] row_mask:0xf bank_mask:0xf
    s_cbranch_vccnz L_skb7
    v_exp_f32 v72, v72
    v_exp_f32 v73, v73
    v_mov_b32 v78, v74
    s_mov_b32 s83, 1114112
    s_sub_u32 s76, s76, 1
    v_mul_f32 v76, v76, v72
    v_mul_f32 v77, v77, v72
    v_mul_f32 v79, v79, v72
    v_fmac_f32 v76, v180, v73
    v_fmac_f32 v77, v181, v73
    v_fmac_f32_dpp v79, v182, v73 quad_perm:[1,1,3,3] row_mask:0xf bank_mask:0xf
    s_cmp_eq_u32 s76, 0
    s_cbranch_scc1 L_done
L_skb7:
    s_nop 0
    s_branch L_ploop
L_done:
    v_rcp_f32 v79, v79
    s_nop 0
    v_mul_f32 v76, v76, v79
    v_mul_f32 v77, v77, v79
    v_cvt_pk_bf16_f32 v76, v76, v77
    buffer_store_dword v76, v192, s[36:39], 0 offen sc1
    s_cmp_lg_u32 s3, 0
    s_cbranch_scc1 L_end
    v_mov_b32 v75, s68
    s_mov_b64 exec, 1
    buffer_store_dword v75, off, s[44:47], s69 sc1
    s_mov_b64 exec, -1
L_end:
L_exit:
    s_endpgm
.section .rodata,"a"
.p2align 6
.amdhsa_kernel standalone__kv_cache_quant_int4_int2_kv_with_per_channel_or_per_token_scales__decode_kernel
  .amdhsa_next_free_vgpr 200
  .amdhsa_next_free_sgpr 92
  .amdhsa_accum_offset 200
  .amdhsa_group_segment_fixed_size 0
  .amdhsa_kernarg_size 80
  .amdhsa_user_sgpr_count 2
  .amdhsa_user_sgpr_kernarg_segment_ptr 1
  .amdhsa_system_sgpr_workgroup_id_x 1
  .amdhsa_float_denorm_mode_32 3
.end_amdhsa_kernel
```
